```python
import torch

def _softmax(x, axis=-1):
    return torch.softmax(x, dim=axis)
def _gelu(x):
    return torch.nn.functional.gelu(x, approximate="tanh")
def _silu(x):
    return torch.nn.functional.silu(x)
def _sigmoid(x):
    return torch.sigmoid(x)
def _layernorm(x, axis=-1, eps=1e-5):
    m = x.mean(dim=axis, keepdim=True)
    v = x.var(dim=axis, keepdim=True, unbiased=False)
    return (x - m) / torch.sqrt(v + eps)
def _scatter_add(tgt, idx, src, axis=0):
    return tgt.clone().index_add_(axis, idx, src)
def _segment_sum(src, seg, n):
    out = torch.zeros((n,) + src.shape[1:], dtype=src.dtype)
    return out.index_add_(0, seg, src)
def _pad(x, pw):
    flat = tuple(v for pair in reversed(pw) for v in pair)
    return torch.nn.functional.pad(x, flat)

kernel_name = 'standalone__kv_cache_quant_int4_int2_kv_with_per_channel_or_per_token_scales__decode'

def setup_inputs():

    _w = (lambda a: (lambda t: t.to(torch.bfloat16) if t.is_floating_point() else t)(torch.as_tensor(a)))
    B = 1
    Sq = 1
    Skv = 32768
    Hq = 32
    Hkv = 8
    Dh = 128
    bits = 4
    G = -1
    if G <= 0 or G >= Skv:
        G = max(1, Skv // 2)
    Skv = (Skv // G) * G
    ngk = Skv // G
    qmax = (1 << bits) - 1
    return {
        "q": _w((lambda *s: torch.randn(*s, dtype=torch.bfloat16) * 1.6)(B, Hq, Sq, Dh)),
        "qk": _w(torch.randint(0, qmax + 1, (B, Hkv, Skv, Dh)).to(torch.int32)),
        "qv": _w(torch.randint(0, qmax + 1, (B, Hkv, Skv, Dh)).to(torch.int32)),
        "k_scales": _w(torch.abs((lambda *s: torch.randn(*s, dtype=torch.bfloat16) * 1.6)(B, Hkv, ngk, Dh)) * 0.05 + 0.02),
        "k_zeros": _w((lambda *s: torch.randn(*s, dtype=torch.bfloat16) * 1.6)(B, Hkv, ngk, Dh) + float(qmax) / 2.0),
        "v_scales": _w(torch.abs((lambda *s: torch.randn(*s, dtype=torch.bfloat16) * 0.05)(B, Hkv, Skv, 1)) * 0.05 + 0.02),
        "v_zeros": _w((lambda *s: torch.randn(*s, dtype=torch.bfloat16) * 0.05)(B, Hkv, Skv, 1) + float(qmax) / 2.0),
    }

def reference(q, qk, qv, k_scales, k_zeros, v_scales, v_zeros):
    B, Hq, Sq, Dh = q.shape
    Hkv, Skv = qk.shape[1], qk.shape[2]
    ngk = k_scales.shape[2]
    G = Skv // ngk
    ks = (lambda x, n, axis: torch.repeat_interleave(x, n, dim=axis))(k_scales, G, axis=2)
    kz = (lambda x, n, axis: torch.repeat_interleave(x, n, dim=axis))(k_zeros, G, axis=2)
    k = ((lambda x, dt: x.to(dt))(qk, q.dtype) - kz) * ks
    v = ((lambda x, dt: x.to(dt))(qv, q.dtype) - v_zeros) * v_scales
    rep = Hq // Hkv
    if rep > 1:
        k = (lambda x, n, axis: torch.repeat_interleave(x, n, dim=axis))(k, rep, axis=1)
        v = (lambda x, n, axis: torch.repeat_interleave(x, n, dim=axis))(v, rep, axis=1)
    scale = float(Dh) ** -0.5
    logits = torch.einsum("bhqd,bhkd->bhqk", q, k) * scale
    p = _softmax(logits, axis=-1)
    o = torch.einsum("bhqk,bhkd->bhqd", p, v)
    return o
```

```asm
; @launch grid=(256,1,1) block=(256,1,1) lds=20736
.amdgcn_target "amdgcn-amd-amdhsa--gfx950"
.text
.globl standalone__kv_cache_quant_int4_int2_kv_with_per_channel_or_per_token_scales__decode_kernel
.p2align 8
.type standalone__kv_cache_quant_int4_int2_kv_with_per_channel_or_per_token_scales__decode_kernel,@function
standalone__kv_cache_quant_int4_int2_kv_with_per_channel_or_per_token_scales__decode_kernel:
  s_cmp_ge_u32 s2, 256
  s_cbranch_scc1 L_end
  s_load_dwordx16 s[4:19], s[0:1], 0
  s_load_dwordx4 s[20:23], s[0:1], 64
  v_lshrrev_b32 v9, 6, v0
  v_and_b32 v1, 63, v0
  v_readfirstlane_b32 s24, v9
  v_and_b32 v10, 15, v1
  v_lshrrev_b32 v11, 4, v1
  s_and_b32 s25, s2, 7
  s_lshr_b32 s26, s2, 3
  v_lshlrev_b32 v4, 4, v11
  v_lshl_add_u32 v2, v10, 9, v4
  v_lshlrev_b32 v12, 4, v10
  v_lshl_add_u32 v3, v11, 11, v12
  s_lshl_b32 s27, s24, 5
  s_add_u32 s27, s27, s26
  s_and_b32 s31, s27, 15
  s_lshr_b32 s50, s27, 4
  s_lshl_b32 s50, s50, 7
  s_or_b32 s31, s31, s50
  s_lshl_b32 s48, s31, 14
  s_lshl_b32 s31, s25, 24
  s_add_u32 s48, s48, s31
  s_mov_b32 s30, 0
  s_lshl_b32 s31, s25, 10
  v_lshl_add_u32 v14, v1, 4, s31
  s_lshl_b32 s31, s25, 9
  s_lshr_b32 s50, s24, 1
  s_lshl_b32 s50, s50, 8
  s_add_u32 s31, s31, s50
  v_add_u32 v15, s31, v12
  s_lshr_b32 s31, s48, 8
  v_and_b32 v13, 7, v1
  v_lshl_add_u32 v13, v13, 3, s31
  v_lshrrev_b32 v9, 3, v1
  v_lshl_add_u32 v13, v9, 10, v13
  s_add_u32 s31, s30, s25
  s_and_b32 s31, s31, 7
  s_lshl_b32 s29, s31, 6
  s_lshl_b32 s31, s31, 18
  s_add_u32 s28, s31, s48
  s_add_u32 s44, s28, 8192
  s_mov_b32 s34, 0x8000000
  s_mov_b32 s35, 0x20000
  s_mov_b32 s38, 0x8000000
  s_mov_b32 s39, 0x20000
  s_mov_b32 s42, 0x100000
  s_mov_b32 s43, 0x20000
  s_waitcnt lgkmcnt(0)
  s_mov_b32 s32, s6
  s_mov_b32 s33, s7
  s_mov_b32 s36, s8
  s_mov_b32 s37, s9
  s_mov_b32 s40, s22
  s_mov_b32 s41, s23
  global_load_dwordx4 v[68:71], v14, s[4:5]
  global_load_dwordx4 v[72:75], v15, s[10:11]
  global_load_dwordx4 v[76:79], v15, s[12:13]
  global_load_dwordx2 v[80:81], v13, s[14:15] nt
  global_load_dwordx2 v[82:83], v13, s[16:17] nt
  buffer_load_dwordx4 v[128:131], v2, s[32:35], s28 offen offset:0 nt
  buffer_load_dwordx4 v[132:135], v2, s[32:35], s28 offen offset:64 nt
  buffer_load_dwordx4 v[136:139], v2, s[32:35], s28 offen offset:128 nt
  buffer_load_dwordx4 v[140:143], v2, s[32:35], s28 offen offset:192 nt
  buffer_load_dwordx4 v[144:147], v2, s[32:35], s28 offen offset:256 nt
  buffer_load_dwordx4 v[148:151], v2, s[32:35], s28 offen offset:320 nt
  buffer_load_dwordx4 v[152:155], v2, s[32:35], s28 offen offset:384 nt
  buffer_load_dwordx4 v[156:159], v2, s[32:35], s28 offen offset:448 nt
  buffer_load_dwordx4 v[160:163], v2, s[32:35], s44 offen offset:0 nt
  buffer_load_dwordx4 v[164:167], v2, s[32:35], s44 offen offset:64 nt
  buffer_load_dwordx4 v[168:171], v2, s[32:35], s44 offen offset:128 nt
  buffer_load_dwordx4 v[172:175], v2, s[32:35], s44 offen offset:192 nt
  buffer_load_dwordx4 v[176:179], v2, s[32:35], s44 offen offset:256 nt
  buffer_load_dwordx4 v[180:183], v2, s[32:35], s44 offen offset:320 nt
  buffer_load_dwordx4 v[184:187], v2, s[32:35], s44 offen offset:384 nt
  buffer_load_dwordx4 v[188:191], v2, s[32:35], s44 offen offset:448 nt
  buffer_load_dwordx4 v[192:195], v3, s[36:39], s28 offen offset:0 nt
  buffer_load_dwordx4 v[196:199], v3, s[36:39], s28 offen offset:512 nt
  buffer_load_dwordx4 v[200:203], v3, s[36:39], s28 offen offset:1024 nt
  buffer_load_dwordx4 v[204:207], v3, s[36:39], s28 offen offset:1536 nt
  buffer_load_dwordx4 v[208:211], v3, s[36:39], s44 offen offset:0 nt
  buffer_load_dwordx4 v[212:215], v3, s[36:39], s44 offen offset:512 nt
  buffer_load_dwordx4 v[216:219], v3, s[36:39], s44 offen offset:1024 nt
  buffer_load_dwordx4 v[220:223], v3, s[36:39], s44 offen offset:1536 nt
  buffer_load_dwordx4 v[224:227], v3, s[36:39], s28 offen offset:256 nt
  buffer_load_dwordx4 v[228:231], v3, s[36:39], s28 offen offset:768 nt
  buffer_load_dwordx4 v[232:235], v3, s[36:39], s28 offen offset:1280 nt
  buffer_load_dwordx4 v[236:239], v3, s[36:39], s28 offen offset:1792 nt
  buffer_load_dwordx4 v[240:243], v3, s[36:39], s44 offen offset:256 nt
  buffer_load_dwordx4 v[244:247], v3, s[36:39], s44 offen offset:768 nt
  buffer_load_dwordx4 v[248:251], v3, s[36:39], s44 offen offset:1280 nt
  buffer_load_dwordx4 v[252:255], v3, s[36:39], s44 offen offset:1792 nt
  s_mov_b32 s45, 0x3e0293ee
  s_mov_b32 s46, 0x07060302
  s_mov_b32 s47, 0xffff0000
  s_lshl_b32 s49, s25, 5
  v_mov_b32 v122, s49
  s_add_u32 s49, s49, s26
  s_lshl_b32 s49, s49, 12
  s_lshl_b32 s51, s25, 17
  s_lshl_b32 s50, s24, 12
  v_bfe_i32 v5, v1, 2, 1
  v_and_b32 v5, s47, v5
  v_mov_b32 v6, 0xff800000
  v_mov_b32 v7, 0
  v_mov_b32 v123, 1
  v_mov_b32 v121, 16512
  v_mov_b32 v32, 0
  v_mov_b32 v33, 0
  v_mov_b32 v34, 0
  v_mov_b32 v35, 0
  v_mov_b32 v36, 0
  v_mov_b32 v37, 0
  v_mov_b32 v38, 0
  v_mov_b32 v39, 0
  v_mov_b32 v40, 0
  v_mov_b32 v41, 0
  v_mov_b32 v42, 0
  v_mov_b32 v43, 0
  v_mov_b32 v44, 0
  v_mov_b32 v45, 0
  v_mov_b32 v46, 0
  v_mov_b32 v47, 0
  v_mov_b32 v48, 0
  v_mov_b32 v49, 0
  v_mov_b32 v50, 0
  v_mov_b32 v51, 0
  v_mov_b32 v52, 0
  v_mov_b32 v53, 0
  v_mov_b32 v54, 0
  v_mov_b32 v55, 0
  v_mov_b32 v56, 0
  v_mov_b32 v57, 0
  v_mov_b32 v58, 0
  v_mov_b32 v59, 0
  v_mov_b32 v60, 0
  v_mov_b32 v61, 0
  v_mov_b32 v62, 0
  v_mov_b32 v63, 0
  v_mov_b32 v64, 0
  v_mov_b32 v65, 0
  v_mov_b32 v66, 0
  v_mov_b32 v67, 0
  v_and_b32 v115, 16, v4
  v_lshl_add_u32 v115, v115, 7, v12
  v_add_u32 v115, s50, v115
  s_lshl_b32 s31, s24, 2
  s_add_u32 s31, s31, 16384
  v_lshl_add_u32 v117, v1, 4, s31
  v_and_b32 v9, 31, v1
  v_lshrrev_b32 v11, 5, v1
  s_lshl_b32 s31, s24, 9
  v_lshl_add_u32 v113, v9, 4, s31
  v_lshl_add_u32 v116, v11, 11, v113
  v_lshl_add_u32 v114, v11, 16, v113
  s_lshl_b32 s31, s24, 4
  v_mov_b32 v118, s31
  s_add_u32 s31, s31, 2048
  v_writelane_b32 v113, s31, 32
  v_lshl_add_u32 v10, v11, 4, v10
  v_lshl_add_u32 v119, v10, 12, s31
  s_lshl_b32 s31, s25, 2
  s_add_u32 s31, s31, s24
  s_lshl_b32 s31, s31, 8
  v_lshl_add_u32 v120, v1, 3, s31
  v_bfe_u32 v9, v1, 2, 2
  v_lshl_add_u32 v12, v9, 6, s50
  v_bfe_u32 v9, v1, 1, 1
  v_lshl_add_u32 v12, v9, 3, v12
  v_and_b32 v9, 1, v1
  v_lshl_add_u32 v12, v9, 5, v12
  v_add_u32 v14, 2048, v12
  v_lshl_add_u32 v12, v4, 4, v12
  v_add_u32 v13, s50, v4
  v_and_b32 v9, 7, v1
  v_lshl_add_u32 v15, v9, 8, v13
  s_lshl_b32 s31, s24, 10
  s_add_u32 s31, s31, 16640
  v_lshl_add_u32 v10, v1, 3, s31
  v_lshrrev_b32 v112, 1, v4
  v_add_u32 v112, s31, v112
  s_waitcnt vmcnt(32)
  ds_write_b64 v10, v[80:81]
  ds_write_b64 v10, v[82:83] offset:512
  ds_write2_b64 v14, v[76:77], v[78:79] offset0:0 offset1:2
  v_lshlrev_b32 v104, 16, v68
  v_and_b32 v105, s47, v68
  v_lshlrev_b32 v106, 16, v72
  v_and_b32 v107, s47, v72
  v_mul_f32 v104, v104, v106
  v_mul_f32 v105, v105, v107
  v_cvt_pk_bf16_f32 v96, v104, v105
  v_lshlrev_b32 v106, 16, v96
  v_and_b32 v107, s47, v96
  v_sub_f32 v104, v104, v106
  v_sub_f32 v105, v105, v107
  v_cvt_pk_bf16_f32 v100, v104, v105
  v_lshlrev_b32 v104, 16, v69
  v_and_b32 v105, s47, v69
  v_lshlrev_b32 v106, 16, v73
  v_and_b32 v107, s47, v73
  v_mul_f32 v104, v104, v106
  v_mul_f32 v105, v105, v107
  v_cvt_pk_bf16_f32 v97, v104, v105
  v_lshlrev_b32 v106, 16, v97
  v_and_b32 v107, s47, v97
  v_sub_f32 v104, v104, v106
  v_sub_f32 v105, v105, v107
  v_cvt_pk_bf16_f32 v101, v104, v105
  v_lshlrev_b32 v104, 16, v70
  v_and_b32 v105, s47, v70
  v_lshlrev_b32 v106, 16, v74
  v_and_b32 v107, s47, v74
  v_mul_f32 v104, v104, v106
  v_mul_f32 v105, v105, v107
  v_cvt_pk_bf16_f32 v98, v104, v105
  v_lshlrev_b32 v106, 16, v98
  v_and_b32 v107, s47, v98
  v_sub_f32 v104, v104, v106
  v_sub_f32 v105, v105, v107
  v_cvt_pk_bf16_f32 v102, v104, v105
  v_lshlrev_b32 v104, 16, v71
  v_and_b32 v105, s47, v71
  v_lshlrev_b32 v106, 16, v75
  v_and_b32 v107, s47, v75
  v_mul_f32 v104, v104, v106
  v_mul_f32 v105, v105, v107
  v_cvt_pk_bf16_f32 v99, v104, v105
  v_lshlrev_b32 v106, 16, v99
  v_and_b32 v107, s47, v99
  v_sub_f32 v104, v104, v106
  v_sub_f32 v105, v105, v107
  v_cvt_pk_bf16_f32 v103, v104, v105
  ds_write2_b64 v12, v[96:97], v[98:99] offset0:0 offset1:2
  ds_write2_b64 v12, v[100:101], v[102:103] offset0:128 offset1:130
  s_waitcnt lgkmcnt(0)
  ds_read_b128 v[16:19], v15 offset:0
  ds_read_b128 v[20:23], v15 offset:64
  ds_read_b128 v[24:27], v15 offset:128
  ds_read_b128 v[28:31], v15 offset:192
  ds_read_b128 v[96:99], v13 offset:2048
  ds_read_b128 v[100:103], v13 offset:2112
  ds_read_b128 v[104:107], v13 offset:2176
  ds_read_b128 v[108:111], v13 offset:2240
  s_waitcnt lgkmcnt(0)
  v_mfma_f32_16x16x32_bf16 v[68:71], v[96:99], v[16:19], 0
  v_mfma_f32_16x16x32_bf16 v[68:71], v[100:103], v[20:23], v[68:71]
  v_mfma_f32_16x16x32_bf16 v[68:71], v[104:107], v[24:27], v[68:71]
  v_mfma_f32_16x16x32_bf16 v[68:71], v[108:111], v[28:31], v[68:71]
  s_nop 7
  v_add_f32_dpp v8, v68, v68 row_ror:4 row_mask:0xf bank_mask:0xf
  s_branch L_body
  s_nop 0
L_loop:
  buffer_load_dwordx4 v[128:131], v2, s[32:35], s28 offen offset:0 nt
  buffer_load_dwordx4 v[132:135], v2, s[32:35], s28 offen offset:64 nt
  buffer_load_dwordx4 v[136:139], v2, s[32:35], s28 offen offset:128 nt
  buffer_load_dwordx4 v[140:143], v2, s[32:35], s28 offen offset:192 nt
  buffer_load_dwordx4 v[144:147], v2, s[32:35], s28 offen offset:256 nt
  buffer_load_dwordx4 v[148:151], v2, s[32:35], s28 offen offset:320 nt
  buffer_load_dwordx4 v[152:155], v2, s[32:35], s28 offen offset:384 nt
  buffer_load_dwordx4 v[156:159], v2, s[32:35], s28 offen offset:448 nt
  buffer_load_dwordx4 v[160:163], v2, s[32:35], s44 offen offset:0 nt
  buffer_load_dwordx4 v[164:167], v2, s[32:35], s44 offen offset:64 nt
  buffer_load_dwordx4 v[168:171], v2, s[32:35], s44 offen offset:128 nt
  buffer_load_dwordx4 v[172:175], v2, s[32:35], s44 offen offset:192 nt
  buffer_load_dwordx4 v[176:179], v2, s[32:35], s44 offen offset:256 nt
  buffer_load_dwordx4 v[180:183], v2, s[32:35], s44 offen offset:320 nt
  buffer_load_dwordx4 v[184:187], v2, s[32:35], s44 offen offset:384 nt
  buffer_load_dwordx4 v[188:191], v2, s[32:35], s44 offen offset:448 nt
  buffer_load_dwordx4 v[192:195], v3, s[36:39], s28 offen offset:0 nt
  buffer_load_dwordx4 v[196:199], v3, s[36:39], s28 offen offset:512 nt
  buffer_load_dwordx4 v[200:203], v3, s[36:39], s28 offen offset:1024 nt
  buffer_load_dwordx4 v[204:207], v3, s[36:39], s28 offen offset:1536 nt
  buffer_load_dwordx4 v[208:211], v3, s[36:39], s44 offen offset:0 nt
  buffer_load_dwordx4 v[212:215], v3, s[36:39], s44 offen offset:512 nt
  buffer_load_dwordx4 v[216:219], v3, s[36:39], s44 offen offset:1024 nt
  buffer_load_dwordx4 v[220:223], v3, s[36:39], s44 offen offset:1536 nt
  buffer_load_dwordx4 v[224:227], v3, s[36:39], s28 offen offset:256 nt
  buffer_load_dwordx4 v[228:231], v3, s[36:39], s28 offen offset:768 nt
  buffer_load_dwordx4 v[232:235], v3, s[36:39], s28 offen offset:1280 nt
  buffer_load_dwordx4 v[236:239], v3, s[36:39], s28 offen offset:1792 nt
  buffer_load_dwordx4 v[240:243], v3, s[36:39], s44 offen offset:256 nt
  buffer_load_dwordx4 v[244:247], v3, s[36:39], s44 offen offset:768 nt
  buffer_load_dwordx4 v[248:251], v3, s[36:39], s44 offen offset:1280 nt
  buffer_load_dwordx4 v[252:255], v3, s[36:39], s44 offen offset:1792 nt
L_body:
  v_add_u32 v9, s29, v112
  ds_read2_b64 v[80:83], v9 offset0:0 offset1:4
  ds_read2_b64 v[84:87], v9 offset0:64 offset1:68
  s_waitcnt vmcnt(31)
  v_cvt_f32_i32 v128, v128
  v_cvt_f32_i32 v129, v129
  v_cvt_f32_i32 v130, v130
  v_cvt_f32_i32 v131, v131
  v_cvt_pk_bf16_f32 v128, v128, v129
  v_cvt_pk_bf16_f32 v129, v130, v131
  s_waitcnt vmcnt(30)
  v_cvt_f32_i32 v132, v132
  v_cvt_f32_i32 v133, v133
  v_cvt_f32_i32 v134, v134
  v_cvt_f32_i32 v135, v135
  v_cvt_pk_bf16_f32 v130, v132, v133
  v_cvt_pk_bf16_f32 v131, v134, v135
  s_waitcnt vmcnt(29)
  v_cvt_f32_i32 v136, v136
  v_cvt_f32_i32 v137, v137
  v_mfma_f32_16x16x32_bf16 v[68:71], v[128:131], v[16:19], 0
  v_cvt_f32_i32 v138, v138
  v_cvt_f32_i32 v139, v139
  v_cvt_pk_bf16_f32 v136, v136, v137
  v_cvt_pk_bf16_f32 v137, v138, v139
  s_waitcnt vmcnt(28)
  v_cvt_f32_i32 v140, v140
  v_cvt_f32_i32 v141, v141
  v_cvt_f32_i32 v142, v142
  v_cvt_f32_i32 v143, v143
  v_cvt_pk_bf16_f32 v138, v140, v141
  v_cvt_pk_bf16_f32 v139, v142, v143
  s_waitcnt vmcnt(27)
  v_cvt_f32_i32 v144, v144
  v_cvt_f32_i32 v145, v145
  v_mfma_f32_16x16x32_bf16 v[68:71], v[136:139], v[20:23], v[68:71]
  v_cvt_f32_i32 v146, v146
  v_cvt_f32_i32 v147, v147
  v_cvt_pk_bf16_f32 v144, v144, v145
  v_cvt_pk_bf16_f32 v145, v146, v147
  s_waitcnt vmcnt(26)
  v_cvt_f32_i32 v148, v148
  v_cvt_f32_i32 v149, v149
  v_cvt_f32_i32 v150, v150
  v_cvt_f32_i32 v151, v151
  v_cvt_pk_bf16_f32 v146, v148, v149
  v_cvt_pk_bf16_f32 v147, v150, v151
  s_waitcnt vmcnt(25)
  v_cvt_f32_i32 v152, v152
  v_cvt_f32_i32 v153, v153
  v_mfma_f32_16x16x32_bf16 v[68:71], v[144:147], v[24:27], v[68:71]
  v_cvt_f32_i32 v154, v154
  v_cvt_f32_i32 v155, v155
  v_cvt_pk_bf16_f32 v152, v152, v153
  v_cvt_pk_bf16_f32 v153, v154, v155
  s_waitcnt vmcnt(24)
  v_cvt_f32_i32 v156, v156
  v_cvt_f32_i32 v157, v157
  v_cvt_f32_i32 v158, v158
  v_cvt_f32_i32 v159, v159
  v_cvt_pk_bf16_f32 v154, v156, v157
  v_cvt_pk_bf16_f32 v155, v158, v159
  s_waitcnt vmcnt(23)
  v_cvt_f32_i32 v160, v160
  v_cvt_f32_i32 v161, v161
  v_mfma_f32_16x16x32_bf16 v[68:71], v[152:155], v[28:31], v[68:71]
  v_cvt_f32_i32 v162, v162
  v_cvt_f32_i32 v163, v163
  v_cvt_pk_bf16_f32 v160, v160, v161
  v_cvt_pk_bf16_f32 v161, v162, v163
  s_waitcnt vmcnt(22)
  v_cvt_f32_i32 v164, v164
  v_cvt_f32_i32 v165, v165
  v_cvt_f32_i32 v166, v166
  v_cvt_f32_i32 v167, v167
  v_cvt_pk_bf16_f32 v162, v164, v165
  v_cvt_pk_bf16_f32 v163, v166, v167
  s_waitcnt vmcnt(21)
  v_cvt_f32_i32 v168, v168
  v_cvt_f32_i32 v169, v169
  v_mfma_f32_16x16x32_bf16 v[72:75], v[160:163], v[16:19], 0
  v_cvt_f32_i32 v170, v170
  v_cvt_f32_i32 v171, v171
  v_cvt_pk_bf16_f32 v168, v168, v169
  v_cvt_pk_bf16_f32 v169, v170, v171
  s_waitcnt vmcnt(20)
  v_cvt_f32_i32 v172, v172
  v_cvt_f32_i32 v173, v173
  v_cvt_f32_i32 v174, v174
  v_cvt_f32_i32 v175, v175
  v_cvt_pk_bf16_f32 v170, v172, v173
  v_cvt_pk_bf16_f32 v171, v174, v175
  s_waitcnt vmcnt(19)
  v_cvt_f32_i32 v176, v176
  v_cvt_f32_i32 v177, v177
  v_mfma_f32_16x16x32_bf16 v[72:75], v[168:171], v[20:23], v[72:75]
  v_cvt_f32_i32 v178, v178
  v_cvt_f32_i32 v179, v179
  v_cvt_pk_bf16_f32 v176, v176, v177
  v_cvt_pk_bf16_f32 v177, v178, v179
  s_waitcnt vmcnt(18)
  v_cvt_f32_i32 v180, v180
  v_cvt_f32_i32 v181, v181
  v_cvt_f32_i32 v182, v182
  v_cvt_f32_i32 v183, v183
  v_cvt_pk_bf16_f32 v178, v180, v181
  v_cvt_pk_bf16_f32 v179, v182, v183
  s_waitcnt vmcnt(17)
  v_cvt_f32_i32 v184, v184
  v_cvt_f32_i32 v185, v185
  v_mfma_f32_16x16x32_bf16 v[72:75], v[176:179], v[24:27], v[72:75]
  v_cvt_f32_i32 v186, v186
  v_cvt_f32_i32 v187, v187
  v_cvt_pk_bf16_f32 v184, v184, v185
  v_cvt_pk_bf16_f32 v185, v186, v187
  s_waitcnt vmcnt(16)
  v_cvt_f32_i32 v188, v188
  v_cvt_f32_i32 v189, v189
  v_cvt_f32_i32 v190, v190
  v_cvt_f32_i32 v191, v191
  v_cvt_pk_bf16_f32 v186, v188, v189
  v_cvt_pk_bf16_f32 v187, v190, v191
  s_waitcnt lgkmcnt(0)
  v_lshlrev_b32 v88, 16, v80
  v_mfma_f32_16x16x32_bf16 v[72:75], v[184:187], v[28:31], v[72:75]
  v_and_b32 v89, s47, v80
  v_lshlrev_b32 v90, 16, v81
  v_and_b32 v91, s47, v81
  v_lshlrev_b32 v92, 16, v82
  v_and_b32 v93, s47, v82
  v_lshlrev_b32 v94, 16, v83
  v_and_b32 v95, s47, v83
  v_add_f32_dpp v68, v68, v68 row_ror:4 row_mask:0xf bank_mask:0xf
  v_add_f32_dpp v69, v69, v69 row_ror:4 row_mask:0xf bank_mask:0xf
  v_add_f32_dpp v70, v70, v70 row_ror:4 row_mask:0xf bank_mask:0xf
  v_add_f32_dpp v71, v71, v71 row_ror:4 row_mask:0xf bank_mask:0xf
  v_add_f32_dpp v72, v72, v72 row_ror:4 row_mask:0xf bank_mask:0xf
  v_add_f32_dpp v73, v73, v73 row_ror:4 row_mask:0xf bank_mask:0xf
  v_add_f32_dpp v74, v74, v74 row_ror:4 row_mask:0xf bank_mask:0xf
  v_add_f32_dpp v75, v75, v75 row_ror:4 row_mask:0xf bank_mask:0xf
  v_max3_f32 v9, v68, v69, v70
  v_max3_f32 v10, v71, v72, v73
  v_max3_f32 v9, v9, v74, v75
  v_max_f32 v9, v9, v10
  v_mov_b32 v10, v9
  s_nop 1
  v_permlane32_swap_b32 v10, v9
  v_max_f32 v9, v9, v10
  v_mov_b32 v10, v9
  s_nop 1
  v_permlane16_swap_b32 v10, v9
  v_max_f32 v9, v9, v10
  v_mul_f32 v9, s45, v9
  v_max_f32 v9, v9, v6
  v_sub_f32 v10, v6, v9
  v_mov_b32 v6, v9
  v_exp_f32 v10, v10
  v_fma_f32 v68, v68, s45, -v6
  v_fma_f32 v69, v69, s45, -v6
  v_fma_f32 v70, v70, s45, -v6
  v_fma_f32 v71, v71, s45, -v6
  v_fma_f32 v72, v72, s45, -v6
  v_fma_f32 v73, v73, s45, -v6
  v_fma_f32 v74, v74, s45, -v6
  v_fma_f32 v75, v75, s45, -v6
  v_exp_f32 v68, v68
  v_exp_f32 v69, v69
  v_exp_f32 v70, v70
  v_exp_f32 v71, v71
  v_exp_f32 v72, v72
  v_exp_f32 v73, v73
  v_exp_f32 v74, v74
  v_exp_f32 v75, v75
  v_mul_f32 v7, v7, v10
  v_add_f32 v11, v68, v69
  v_add_f32 v12, v70, v71
  v_add_f32 v13, v72, v73
  v_add_f32 v14, v74, v75
  v_mul_f32 v68, v68, v88
  v_mul_f32 v69, v69, v89
  v_mul_f32 v70, v70, v90
  v_mul_f32 v71, v71, v91
  v_mul_f32 v72, v72, v92
  v_mul_f32 v73, v73, v93
  v_mul_f32 v74, v74, v94
  v_mul_f32 v75, v75, v95
  v_add_f32 v11, v11, v12
  v_add_f32 v13, v13, v14
  v_and_b32 v88, v5, v68
  v_and_b32 v89, v5, v69
  v_and_b32 v90, v5, v70
  v_and_b32 v91, v5, v71
  v_and_b32 v92, v5, v72
  v_and_b32 v93, v5, v73
  v_and_b32 v94, v5, v74
  v_and_b32 v95, v5, v75
  v_add_f32 v7, v7, v11
  v_sub_f32 v68, v68, v88
  v_sub_f32 v69, v69, v89
  v_sub_f32 v70, v70, v90
  v_sub_f32 v71, v71, v91
  v_sub_f32 v72, v72, v92
  v_sub_f32 v73, v73, v93
  v_sub_f32 v74, v74, v94
  v_sub_f32 v75, v75, v95
  v_add_f32 v7, v7, v13
  v_perm_b32 v76, v69, v68, s46
  v_perm_b32 v77, v71, v70, s46
  v_perm_b32 v78, v73, v72, s46
  v_perm_b32 v79, v75, v74, s46
  v_mul_f32_dpp v32, v10, v32 quad_perm:[0,0,0,0] row_mask:0xf bank_mask:0xf
  v_mul_f32_dpp v33, v10, v33 quad_perm:[1,1,1,1] row_mask:0xf bank_mask:0xf
  v_mul_f32_dpp v34, v10, v34 quad_perm:[2,2,2,2] row_mask:0xf bank_mask:0xf
  v_mul_f32_dpp v35, v10, v35 quad_perm:[3,3,3,3] row_mask:0xf bank_mask:0xf
  v_mul_f32_dpp v36, v10, v36 quad_perm:[0,0,0,0] row_mask:0xf bank_mask:0xf
  v_mul_f32_dpp v37, v10, v37 quad_perm:[1,1,1,1] row_mask:0xf bank_mask:0xf
  v_mul_f32_dpp v38, v10, v38 quad_perm:[2,2,2,2] row_mask:0xf bank_mask:0xf
  v_mul_f32_dpp v39, v10, v39 quad_perm:[3,3,3,3] row_mask:0xf bank_mask:0xf
  v_mul_f32_dpp v40, v10, v40 quad_perm:[0,0,0,0] row_mask:0xf bank_mask:0xf
  v_mul_f32_dpp v41, v10, v41 quad_perm:[1,1,1,1] row_mask:0xf bank_mask:0xf
  v_mul_f32_dpp v42, v10, v42 quad_perm:[2,2,2,2] row_mask:0xf bank_mask:0xf
  v_mul_f32_dpp v43, v10, v43 quad_perm:[3,3,3,3] row_mask:0xf bank_mask:0xf
  v_mul_f32_dpp v44, v10, v44 quad_perm:[0,0,0,0] row_mask:0xf bank_mask:0xf
  v_mul_f32_dpp v45, v10, v45 quad_perm:[1,1,1,1] row_mask:0xf bank_mask:0xf
  v_mul_f32_dpp v46, v10, v46 quad_perm:[2,2,2,2] row_mask:0xf bank_mask:0xf
  v_mul_f32_dpp v47, v10, v47 quad_perm:[3,3,3,3] row_mask:0xf bank_mask:0xf
  v_mul_f32_dpp v48, v10, v48 quad_perm:[0,0,0,0] row_mask:0xf bank_mask:0xf
  v_mul_f32_dpp v49, v10, v49 quad_perm:[1,1,1,1] row_mask:0xf bank_mask:0xf
  v_mul_f32_dpp v50, v10, v50 quad_perm:[2,2,2,2] row_mask:0xf bank_mask:0xf
  v_mul_f32_dpp v51, v10, v51 quad_perm:[3,3,3,3] row_mask:0xf bank_mask:0xf
  v_mul_f32_dpp v52, v10, v52 quad_perm:[0,0,0,0] row_mask:0xf bank_mask:0xf
  v_mul_f32_dpp v53, v10, v53 quad_perm:[1,1,1,1] row_mask:0xf bank_mask:0xf
  v_mul_f32_dpp v54, v10, v54 quad_perm:[2,2,2,2] row_mask:0xf bank_mask:0xf
  v_mul_f32_dpp v55, v10, v55 quad_perm:[3,3,3,3] row_mask:0xf bank_mask:0xf
  v_mul_f32_dpp v56, v10, v56 quad_perm:[0,0,0,0] row_mask:0xf bank_mask:0xf
  v_mul_f32_dpp v57, v10, v57 quad_perm:[1,1,1,1] row_mask:0xf bank_mask:0xf
  v_mul_f32_dpp v58, v10, v58 quad_perm:[2,2,2,2] row_mask:0xf bank_mask:0xf
  v_mul_f32_dpp v59, v10, v59 quad_perm:[3,3,3,3] row_mask:0xf bank_mask:0xf
  v_mul_f32_dpp v60, v10, v60 quad_perm:[0,0,0,0] row_mask:0xf bank_mask:0xf
  v_mul_f32_dpp v61, v10, v61 quad_perm:[1,1,1,1] row_mask:0xf bank_mask:0xf
  v_mul_f32_dpp v62, v10, v62 quad_perm:[2,2,2,2] row_mask:0xf bank_mask:0xf
  v_mul_f32_dpp v63, v10, v63 quad_perm:[3,3,3,3] row_mask:0xf bank_mask:0xf
  v_mul_f32_dpp v64, v10, v64 quad_perm:[0,0,0,0] row_mask:0xf bank_mask:0xf
  v_mul_f32_dpp v65, v10, v65 quad_perm:[1,1,1,1] row_mask:0xf bank_mask:0xf
  v_mul_f32_dpp v66, v10, v66 quad_perm:[2,2,2,2] row_mask:0xf bank_mask:0xf
  v_mul_f32_dpp v67, v10, v67 quad_perm:[3,3,3,3] row_mask:0xf bank_mask:0xf
  s_nop 1
  v_mfma_f32_16x16x32_bf16 v[64:67], v[76:79], v[84:87], v[64:67]
  s_waitcnt vmcnt(15)
  v_cvt_f32_i32 v192, v192
  v_cvt_f32_i32 v193, v193
  v_cvt_f32_i32 v194, v194
  v_cvt_f32_i32 v195, v195
  s_waitcnt vmcnt(14)
  v_cvt_f32_i32 v196, v196
  v_cvt_f32_i32 v197, v197
  v_cvt_f32_i32 v198, v198
  v_cvt_f32_i32 v199, v199
  v_cvt_pk_bf16_f32 v96, v192, v196
  v_cvt_pk_bf16_f32 v100, v193, v197
  v_cvt_pk_bf16_f32 v104, v194, v198
  v_cvt_pk_bf16_f32 v108, v195, v199
  s_waitcnt vmcnt(13)
  v_cvt_f32_i32 v200, v200
  v_cvt_f32_i32 v201, v201
  v_cvt_f32_i32 v202, v202
  v_cvt_f32_i32 v203, v203
  s_waitcnt vmcnt(12)
  v_cvt_f32_i32 v204, v204
  v_cvt_f32_i32 v205, v205
  v_cvt_f32_i32 v206, v206
  v_cvt_f32_i32 v207, v207
  v_cvt_pk_bf16_f32 v97, v200, v204
  v_cvt_pk_bf16_f32 v101, v201, v205
  v_cvt_pk_bf16_f32 v105, v202, v206
  v_cvt_pk_bf16_f32 v109, v203, v207
  s_waitcnt vmcnt(11)
  v_cvt_f32_i32 v208, v208
  v_cvt_f32_i32 v209, v209
  v_cvt_f32_i32 v210, v210
  v_cvt_f32_i32 v211, v211
  s_waitcnt vmcnt(10)
  v_cvt_f32_i32 v212, v212
  v_cvt_f32_i32 v213, v213
  v_cvt_f32_i32 v214, v214
  v_cvt_f32_i32 v215, v215
  v_cvt_pk_bf16_f32 v98, v208, v212
  v_cvt_pk_bf16_f32 v102, v209, v213
  v_cvt_pk_bf16_f32 v106, v210, v214
  v_cvt_pk_bf16_f32 v110, v211, v215
  s_waitcnt vmcnt(9)
  v_cvt_f32_i32 v216, v216
  v_cvt_f32_i32 v217, v217
  v_cvt_f32_i32 v218, v218
  v_cvt_f32_i32 v219, v219
  s_waitcnt vmcnt(8)
  v_cvt_f32_i32 v220, v220
  v_cvt_f32_i32 v221, v221
  v_cvt_f32_i32 v222, v222
  v_cvt_f32_i32 v223, v223
  v_cvt_pk_bf16_f32 v99, v216, v220
  v_cvt_pk_bf16_f32 v103, v217, v221
  v_cvt_pk_bf16_f32 v107, v218, v222
  v_cvt_pk_bf16_f32 v111, v219, v223
  s_waitcnt vmcnt(7)
  v_cvt_f32_i32 v224, v224
  v_cvt_f32_i32 v225, v225
  v_mfma_f32_16x16x32_bf16 v[32:35], v[76:79], v[96:99], v[32:35]
  v_cvt_f32_i32 v226, v226
  v_mfma_f32_16x16x32_bf16 v[36:39], v[76:79], v[100:103], v[36:39]
  v_cvt_f32_i32 v227, v227
  v_mfma_f32_16x16x32_bf16 v[40:43], v[76:79], v[104:107], v[40:43]
  s_waitcnt vmcnt(6)
  v_cvt_f32_i32 v228, v228
  v_mfma_f32_16x16x32_bf16 v[44:47], v[76:79], v[108:111], v[44:47]
  v_cvt_f32_i32 v229, v229
  v_cvt_f32_i32 v230, v230
  v_cvt_f32_i32 v231, v231
  v_cvt_pk_bf16_f32 v96, v224, v228
  v_cvt_pk_bf16_f32 v100, v225, v229
  v_cvt_pk_bf16_f32 v104, v226, v230
  v_cvt_pk_bf16_f32 v108, v227, v231
  s_waitcnt vmcnt(5)
  v_cvt_f32_i32 v232, v232
  v_cvt_f32_i32 v233, v233
  v_cvt_f32_i32 v234, v234
  v_cvt_f32_i32 v235, v235
  s_waitcnt vmcnt(4)
  v_cvt_f32_i32 v236, v236
  v_cvt_f32_i32 v237, v237
  v_cvt_f32_i32 v238, v238
  v_cvt_f32_i32 v239, v239
  v_cvt_pk_bf16_f32 v97, v232, v236
  v_cvt_pk_bf16_f32 v101, v233, v237
  v_cvt_pk_bf16_f32 v105, v234, v238
  v_cvt_pk_bf16_f32 v109, v235, v239
  s_waitcnt vmcnt(3)
  v_cvt_f32_i32 v240, v240
  v_cvt_f32_i32 v241, v241
  v_cvt_f32_i32 v242, v242
  v_cvt_f32_i32 v243, v243
  s_waitcnt vmcnt(2)
  v_cvt_f32_i32 v244, v244
  v_cvt_f32_i32 v245, v245
  v_cvt_f32_i32 v246, v246
  v_cvt_f32_i32 v247, v247
  v_cvt_pk_bf16_f32 v98, v240, v244
  v_cvt_pk_bf16_f32 v102, v241, v245
  v_cvt_pk_bf16_f32 v106, v242, v246
  v_cvt_pk_bf16_f32 v110, v243, v247
  s_waitcnt vmcnt(1)
  v_cvt_f32_i32 v248, v248
  v_cvt_f32_i32 v249, v249
  v_cvt_f32_i32 v250, v250
  v_cvt_f32_i32 v251, v251
  s_waitcnt vmcnt(0)
  v_cvt_f32_i32 v252, v252
  v_cvt_f32_i32 v253, v253
  v_cvt_f32_i32 v254, v254
  v_cvt_f32_i32 v255, v255
  v_cvt_pk_bf16_f32 v99, v248, v252
  v_cvt_pk_bf16_f32 v103, v249, v253
  v_cvt_pk_bf16_f32 v107, v250, v254
  v_cvt_pk_bf16_f32 v111, v251, v255
  s_add_u32 s30, s30, 1
  v_mfma_f32_16x16x32_bf16 v[48:51], v[76:79], v[96:99], v[48:51]
  v_mfma_f32_16x16x32_bf16 v[52:55], v[76:79], v[100:103], v[52:55]
  v_mfma_f32_16x16x32_bf16 v[56:59], v[76:79], v[104:107], v[56:59]
  v_mfma_f32_16x16x32_bf16 v[60:63], v[76:79], v[108:111], v[60:63]
  s_add_u32 s31, s30, s25
  s_and_b32 s31, s31, 7
  s_lshl_b32 s29, s31, 6
  s_lshl_b32 s31, s31, 18
  s_add_u32 s28, s31, s48
  s_add_u32 s44, s28, 8192
  s_cmp_lt_u32 s30, 7
  s_cbranch_scc1 L_loop
  buffer_load_dwordx4 v[128:131], v2, s[32:35], s28 offen offset:0 nt
  buffer_load_dwordx4 v[132:135], v2, s[32:35], s28 offen offset:64 nt
  buffer_load_dwordx4 v[136:139], v2, s[32:35], s28 offen offset:128 nt
  buffer_load_dwordx4 v[140:143], v2, s[32:35], s28 offen offset:192 nt
  buffer_load_dwordx4 v[144:147], v2, s[32:35], s28 offen offset:256 nt
  buffer_load_dwordx4 v[148:151], v2, s[32:35], s28 offen offset:320 nt
  buffer_load_dwordx4 v[152:155], v2, s[32:35], s28 offen offset:384 nt
  buffer_load_dwordx4 v[156:159], v2, s[32:35], s28 offen offset:448 nt
  buffer_load_dwordx4 v[160:163], v2, s[32:35], s44 offen offset:0 nt
  buffer_load_dwordx4 v[164:167], v2, s[32:35], s44 offen offset:64 nt
  buffer_load_dwordx4 v[168:171], v2, s[32:35], s44 offen offset:128 nt
  buffer_load_dwordx4 v[172:175], v2, s[32:35], s44 offen offset:192 nt
  buffer_load_dwordx4 v[176:179], v2, s[32:35], s44 offen offset:256 nt
  buffer_load_dwordx4 v[180:183], v2, s[32:35], s44 offen offset:320 nt
  buffer_load_dwordx4 v[184:187], v2, s[32:35], s44 offen offset:384 nt
  buffer_load_dwordx4 v[188:191], v2, s[32:35], s44 offen offset:448 nt
L_lastbody:
  v_add_u32 v9, s29, v112
  ds_read2_b64 v[80:83], v9 offset0:0 offset1:4
  ds_read2_b64 v[84:87], v9 offset0:64 offset1:68
  s_waitcnt vmcnt(15)
  v_cvt_f32_i32 v128, v128
  v_cvt_f32_i32 v129, v129
  v_cvt_f32_i32 v130, v130
  v_cvt_f32_i32 v131, v131
  v_cvt_pk_bf16_f32 v128, v128, v129
  v_cvt_pk_bf16_f32 v129, v130, v131
  s_waitcnt vmcnt(14)
  v_cvt_f32_i32 v132, v132
  v_cvt_f32_i32 v133, v133
  v_cvt_f32_i32 v134, v134
  v_cvt_f32_i32 v135, v135
  v_cvt_pk_bf16_f32 v130, v132, v133
  v_cvt_pk_bf16_f32 v131, v134, v135
  s_waitcnt vmcnt(13)
  v_cvt_f32_i32 v136, v136
  v_cvt_f32_i32 v137, v137
  v_mfma_f32_16x16x32_bf16 v[68:71], v[128:131], v[16:19], 0
  v_cvt_f32_i32 v138, v138
  v_cvt_f32_i32 v139, v139
  v_cvt_pk_bf16_f32 v136, v136, v137
  v_cvt_pk_bf16_f32 v137, v138, v139
  s_waitcnt vmcnt(12)
  v_cvt_f32_i32 v140, v140
  v_cvt_f32_i32 v141, v141
  v_cvt_f32_i32 v142, v142
  v_cvt_f32_i32 v143, v143
  v_cvt_pk_bf16_f32 v138, v140, v141
  v_cvt_pk_bf16_f32 v139, v142, v143
  s_waitcnt vmcnt(11)
  v_cvt_f32_i32 v144, v144
  v_cvt_f32_i32 v145, v145
  v_mfma_f32_16x16x32_bf16 v[68:71], v[136:139], v[20:23], v[68:71]
  v_cvt_f32_i32 v146, v146
  v_cvt_f32_i32 v147, v147
  v_cvt_pk_bf16_f32 v144, v144, v145
  v_cvt_pk_bf16_f32 v145, v146, v147
  s_waitcnt vmcnt(10)
  v_cvt_f32_i32 v148, v148
  v_cvt_f32_i32 v149, v149
  v_cvt_f32_i32 v150, v150
  v_cvt_f32_i32 v151, v151
  v_cvt_pk_bf16_f32 v146, v148, v149
  v_cvt_pk_bf16_f32 v147, v150, v151
  s_waitcnt vmcnt(9)
  v_cvt_f32_i32 v152, v152
  v_cvt_f32_i32 v153, v153
  v_mfma_f32_16x16x32_bf16 v[68:71], v[144:147], v[24:27], v[68:71]
  v_cvt_f32_i32 v154, v154
  v_cvt_f32_i32 v155, v155
  v_cvt_pk_bf16_f32 v152, v152, v153
  v_cvt_pk_bf16_f32 v153, v154, v155
  s_waitcnt vmcnt(8)
  v_cvt_f32_i32 v156, v156
  v_cvt_f32_i32 v157, v157
  v_cvt_f32_i32 v158, v158
  v_cvt_f32_i32 v159, v159
  v_cvt_pk_bf16_f32 v154, v156, v157
  v_cvt_pk_bf16_f32 v155, v158, v159
  s_waitcnt vmcnt(7)
  v_cvt_f32_i32 v160, v160
  v_cvt_f32_i32 v161, v161
  v_mfma_f32_16x16x32_bf16 v[68:71], v[152:155], v[28:31], v[68:71]
  v_cvt_f32_i32 v162, v162
  v_cvt_f32_i32 v163, v163
  v_cvt_pk_bf16_f32 v160, v160, v161
  v_cvt_pk_bf16_f32 v161, v162, v163
  s_waitcnt vmcnt(6)
  v_cvt_f32_i32 v164, v164
  v_cvt_f32_i32 v165, v165
  v_cvt_f32_i32 v166, v166
  v_cvt_f32_i32 v167, v167
  v_cvt_pk_bf16_f32 v162, v164, v165
  v_cvt_pk_bf16_f32 v163, v166, v167
  s_waitcnt vmcnt(5)
  v_cvt_f32_i32 v168, v168
  v_cvt_f32_i32 v169, v169
  v_mfma_f32_16x16x32_bf16 v[72:75], v[160:163], v[16:19], 0
  v_cvt_f32_i32 v170, v170
  v_cvt_f32_i32 v171, v171
  v_cvt_pk_bf16_f32 v168, v168, v169
  v_cvt_pk_bf16_f32 v169, v170, v171
  s_waitcnt vmcnt(4)
  v_cvt_f32_i32 v172, v172
  v_cvt_f32_i32 v173, v173
  v_cvt_f32_i32 v174, v174
  v_cvt_f32_i32 v175, v175
  v_cvt_pk_bf16_f32 v170, v172, v173
  v_cvt_pk_bf16_f32 v171, v174, v175
  s_waitcnt vmcnt(3)
  v_cvt_f32_i32 v176, v176
  v_cvt_f32_i32 v177, v177
  v_mfma_f32_16x16x32_bf16 v[72:75], v[168:171], v[20:23], v[72:75]
  v_cvt_f32_i32 v178, v178
  v_cvt_f32_i32 v179, v179
  v_cvt_pk_bf16_f32 v176, v176, v177
  v_cvt_pk_bf16_f32 v177, v178, v179
  s_waitcnt vmcnt(2)
  v_cvt_f32_i32 v180, v180
  v_cvt_f32_i32 v181, v181
  v_cvt_f32_i32 v182, v182
  v_cvt_f32_i32 v183, v183
  v_cvt_pk_bf16_f32 v178, v180, v181
  v_cvt_pk_bf16_f32 v179, v182, v183
  s_waitcnt vmcnt(1)
  v_cvt_f32_i32 v184, v184
  v_cvt_f32_i32 v185, v185
  v_mfma_f32_16x16x32_bf16 v[72:75], v[176:179], v[24:27], v[72:75]
  v_cvt_f32_i32 v186, v186
  v_cvt_f32_i32 v187, v187
  v_cvt_pk_bf16_f32 v184, v184, v185
  v_cvt_pk_bf16_f32 v185, v186, v187
  s_waitcnt vmcnt(0)
  v_cvt_f32_i32 v188, v188
  v_cvt_f32_i32 v189, v189
  v_cvt_f32_i32 v190, v190
  v_cvt_f32_i32 v191, v191
  v_cvt_pk_bf16_f32 v186, v188, v189
  v_cvt_pk_bf16_f32 v187, v190, v191
  buffer_load_dwordx4 v[192:195], v3, s[36:39], s28 offen offset:0 nt
  buffer_load_dwordx4 v[196:199], v3, s[36:39], s28 offen offset:512 nt
  buffer_load_dwordx4 v[200:203], v3, s[36:39], s28 offen offset:1024 nt
  buffer_load_dwordx4 v[204:207], v3, s[36:39], s28 offen offset:1536 nt
  buffer_load_dwordx4 v[208:211], v3, s[36:39], s44 offen offset:0 nt
  buffer_load_dwordx4 v[212:215], v3, s[36:39], s44 offen offset:512 nt
  buffer_load_dwordx4 v[216:219], v3, s[36:39], s44 offen offset:1024 nt
  buffer_load_dwordx4 v[220:223], v3, s[36:39], s44 offen offset:1536 nt
  buffer_load_dwordx4 v[224:227], v3, s[36:39], s28 offen offset:256 nt
  buffer_load_dwordx4 v[228:231], v3, s[36:39], s28 offen offset:768 nt
  buffer_load_dwordx4 v[232:235], v3, s[36:39], s28 offen offset:1280 nt
  buffer_load_dwordx4 v[236:239], v3, s[36:39], s28 offen offset:1792 nt
  buffer_load_dwordx4 v[240:243], v3, s[36:39], s44 offen offset:256 nt
  buffer_load_dwordx4 v[244:247], v3, s[36:39], s44 offen offset:768 nt
  buffer_load_dwordx4 v[248:251], v3, s[36:39], s44 offen offset:1280 nt
  buffer_load_dwordx4 v[252:255], v3, s[36:39], s44 offen offset:1792 nt
  s_waitcnt lgkmcnt(0)
  v_lshlrev_b32 v88, 16, v80
  v_mfma_f32_16x16x32_bf16 v[72:75], v[184:187], v[28:31], v[72:75]
  v_and_b32 v89, s47, v80
  v_lshlrev_b32 v90, 16, v81
  v_and_b32 v91, s47, v81
  v_lshlrev_b32 v92, 16, v82
  v_and_b32 v93, s47, v82
  v_lshlrev_b32 v94, 16, v83
  v_and_b32 v95, s47, v83
  v_add_f32_dpp v68, v68, v68 row_ror:4 row_mask:0xf bank_mask:0xf
  v_add_f32_dpp v69, v69, v69 row_ror:4 row_mask:0xf bank_mask:0xf
  v_add_f32_dpp v70, v70, v70 row_ror:4 row_mask:0xf bank_mask:0xf
  v_add_f32_dpp v71, v71, v71 row_ror:4 row_mask:0xf bank_mask:0xf
  v_add_f32_dpp v72, v72, v72 row_ror:4 row_mask:0xf bank_mask:0xf
  v_add_f32_dpp v73, v73, v73 row_ror:4 row_mask:0xf bank_mask:0xf
  v_add_f32_dpp v74, v74, v74 row_ror:4 row_mask:0xf bank_mask:0xf
  v_add_f32_dpp v75, v75, v75 row_ror:4 row_mask:0xf bank_mask:0xf
  v_max3_f32 v9, v68, v69, v70
  v_max3_f32 v10, v71, v72, v73
  v_max3_f32 v9, v9, v74, v75
  v_max_f32 v9, v9, v10
  v_mov_b32 v10, v9
  s_nop 1
  v_permlane32_swap_b32 v10, v9
  v_max_f32 v9, v9, v10
  v_mov_b32 v10, v9
  s_nop 1
  v_permlane16_swap_b32 v10, v9
  v_max_f32 v9, v9, v10
  v_mul_f32 v9, s45, v9
  v_max_f32 v9, v9, v6
  v_sub_f32 v10, v6, v9
  v_mov_b32 v6, v9
  v_exp_f32 v10, v10
  v_fma_f32 v68, v68, s45, -v6
  v_fma_f32 v69, v69, s45, -v6
  v_fma_f32 v70, v70, s45, -v6
  v_fma_f32 v71, v71, s45, -v6
  v_fma_f32 v72, v72, s45, -v6
  v_fma_f32 v73, v73, s45, -v6
  v_fma_f32 v74, v74, s45, -v6
  v_fma_f32 v75, v75, s45, -v6
  v_exp_f32 v68, v68
  v_exp_f32 v69, v69
  v_exp_f32 v70, v70
  v_exp_f32 v71, v71
  v_exp_f32 v72, v72
  v_exp_f32 v73, v73
  v_exp_f32 v74, v74
  v_exp_f32 v75, v75
  v_mul_f32 v7, v7, v10
  v_add_f32 v11, v68, v69
  v_add_f32 v12, v70, v71
  v_add_f32 v13, v72, v73
  v_add_f32 v14, v74, v75
  v_mul_f32 v68, v68, v88
  v_mul_f32 v69, v69, v89
  v_mul_f32 v70, v70, v90
  v_mul_f32 v71, v71, v91
  v_mul_f32 v72, v72, v92
  v_mul_f32 v73, v73, v93
  v_mul_f32 v74, v74, v94
  v_mul_f32 v75, v75, v95
  v_add_f32 v11, v11, v12
  v_add_f32 v13, v13, v14
  v_and_b32 v88, v5, v68
  v_and_b32 v89, v5, v69
  v_and_b32 v90, v5, v70
  v_and_b32 v91, v5, v71
  v_and_b32 v92, v5, v72
  v_and_b32 v93, v5, v73
  v_and_b32 v94, v5, v74
  v_and_b32 v95, v5, v75
  v_add_f32 v7, v7, v11
  v_sub_f32 v68, v68, v88
  v_sub_f32 v69, v69, v89
  v_sub_f32 v70, v70, v90
  v_sub_f32 v71, v71, v91
  v_sub_f32 v72, v72, v92
  v_sub_f32 v73, v73, v93
  v_sub_f32 v74, v74, v94
  v_sub_f32 v75, v75, v95
  v_add_f32 v7, v7, v13
  v_perm_b32 v76, v69, v68, s46
  v_perm_b32 v77, v71, v70, s46
  v_perm_b32 v78, v73, v72, s46
  v_perm_b32 v79, v75, v74, s46
  v_mul_f32_dpp v32, v10, v32 quad_perm:[0,0,0,0] row_mask:0xf bank_mask:0xf
  v_mul_f32_dpp v33, v10, v33 quad_perm:[1,1,1,1] row_mask:0xf bank_mask:0xf
  v_mul_f32_dpp v34, v10, v34 quad_perm:[2,2,2,2] row_mask:0xf bank_mask:0xf
  v_mul_f32_dpp v35, v10, v35 quad_perm:[3,3,3,3] row_mask:0xf bank_mask:0xf
  v_mul_f32_dpp v36, v10, v36 quad_perm:[0,0,0,0] row_mask:0xf bank_mask:0xf
  v_mul_f32_dpp v37, v10, v37 quad_perm:[1,1,1,1] row_mask:0xf bank_mask:0xf
  v_mul_f32_dpp v38, v10, v38 quad_perm:[2,2,2,2] row_mask:0xf bank_mask:0xf
  v_mul_f32_dpp v39, v10, v39 quad_perm:[3,3,3,3] row_mask:0xf bank_mask:0xf
  v_mul_f32_dpp v40, v10, v40 quad_perm:[0,0,0,0] row_mask:0xf bank_mask:0xf
  v_mul_f32_dpp v41, v10, v41 quad_perm:[1,1,1,1] row_mask:0xf bank_mask:0xf
  v_mul_f32_dpp v42, v10, v42 quad_perm:[2,2,2,2] row_mask:0xf bank_mask:0xf
  v_mul_f32_dpp v43, v10, v43 quad_perm:[3,3,3,3] row_mask:0xf bank_mask:0xf
  v_mul_f32_dpp v44, v10, v44 quad_perm:[0,0,0,0] row_mask:0xf bank_mask:0xf
  v_mul_f32_dpp v45, v10, v45 quad_perm:[1,1,1,1] row_mask:0xf bank_mask:0xf
  v_mul_f32_dpp v46, v10, v46 quad_perm:[2,2,2,2] row_mask:0xf bank_mask:0xf
  v_mul_f32_dpp v47, v10, v47 quad_perm:[3,3,3,3] row_mask:0xf bank_mask:0xf
  v_mul_f32_dpp v48, v10, v48 quad_perm:[0,0,0,0] row_mask:0xf bank_mask:0xf
  v_mul_f32_dpp v49, v10, v49 quad_perm:[1,1,1,1] row_mask:0xf bank_mask:0xf
  v_mul_f32_dpp v50, v10, v50 quad_perm:[2,2,2,2] row_mask:0xf bank_mask:0xf
  v_mul_f32_dpp v51, v10, v51 quad_perm:[3,3,3,3] row_mask:0xf bank_mask:0xf
  v_mul_f32_dpp v52, v10, v52 quad_perm:[0,0,0,0] row_mask:0xf bank_mask:0xf
  v_mul_f32_dpp v53, v10, v53 quad_perm:[1,1,1,1] row_mask:0xf bank_mask:0xf
  v_mul_f32_dpp v54, v10, v54 quad_perm:[2,2,2,2] row_mask:0xf bank_mask:0xf
  v_mul_f32_dpp v55, v10, v55 quad_perm:[3,3,3,3] row_mask:0xf bank_mask:0xf
  v_mul_f32_dpp v56, v10, v56 quad_perm:[0,0,0,0] row_mask:0xf bank_mask:0xf
  v_mul_f32_dpp v57, v10, v57 quad_perm:[1,1,1,1] row_mask:0xf bank_mask:0xf
  v_mul_f32_dpp v58, v10, v58 quad_perm:[2,2,2,2] row_mask:0xf bank_mask:0xf
  v_mul_f32_dpp v59, v10, v59 quad_perm:[3,3,3,3] row_mask:0xf bank_mask:0xf
  v_mul_f32_dpp v60, v10, v60 quad_perm:[0,0,0,0] row_mask:0xf bank_mask:0xf
  v_mul_f32_dpp v61, v10, v61 quad_perm:[1,1,1,1] row_mask:0xf bank_mask:0xf
  v_mul_f32_dpp v62, v10, v62 quad_perm:[2,2,2,2] row_mask:0xf bank_mask:0xf
  v_mul_f32_dpp v63, v10, v63 quad_perm:[3,3,3,3] row_mask:0xf bank_mask:0xf
  v_mul_f32_dpp v64, v10, v64 quad_perm:[0,0,0,0] row_mask:0xf bank_mask:0xf
  v_mul_f32_dpp v65, v10, v65 quad_perm:[1,1,1,1] row_mask:0xf bank_mask:0xf
  v_mul_f32_dpp v66, v10, v66 quad_perm:[2,2,2,2] row_mask:0xf bank_mask:0xf
  v_mul_f32_dpp v67, v10, v67 quad_perm:[3,3,3,3] row_mask:0xf bank_mask:0xf
  s_nop 1
  v_mfma_f32_16x16x32_bf16 v[64:67], v[76:79], v[84:87], v[64:67]
  v_mov_b32 v10, v7
  v_fma_f32 v6, v8, -s45, v6
  s_nop 0
  v_permlane32_swap_b32 v10, v7
  v_add_f32 v7, v7, v10
  v_mov_b32 v10, v7
  s_nop 1
  v_permlane16_swap_b32 v10, v7
  v_add_f32 v7, v7, v10
  s_mov_b64 exec, 15
  ds_write_b32 v117, v6
  ds_write_b32 v117, v7 offset:64
  s_mov_b64 exec, -1
  s_waitcnt vmcnt(15)
  v_cvt_f32_i32 v192, v192
  v_cvt_f32_i32 v193, v193
  v_cvt_f32_i32 v194, v194
  v_cvt_f32_i32 v195, v195
  s_waitcnt vmcnt(14)
  v_cvt_f32_i32 v196, v196
  v_cvt_f32_i32 v197, v197
  v_cvt_f32_i32 v198, v198
  v_cvt_f32_i32 v199, v199
  v_cvt_pk_bf16_f32 v96, v192, v196
  v_cvt_pk_bf16_f32 v100, v193, v197
  v_cvt_pk_bf16_f32 v104, v194, v198
  v_cvt_pk_bf16_f32 v108, v195, v199
  s_waitcnt vmcnt(13)
  v_cvt_f32_i32 v200, v200
  v_cvt_f32_i32 v201, v201
  v_cvt_f32_i32 v202, v202
  v_cvt_f32_i32 v203, v203
  s_waitcnt vmcnt(12)
  v_cvt_f32_i32 v204, v204
  v_cvt_f32_i32 v205, v205
  v_cvt_f32_i32 v206, v206
  v_cvt_f32_i32 v207, v207
  v_cvt_pk_bf16_f32 v97, v200, v204
  v_cvt_pk_bf16_f32 v101, v201, v205
  v_cvt_pk_bf16_f32 v105, v202, v206
  v_cvt_pk_bf16_f32 v109, v203, v207
  s_waitcnt vmcnt(11)
  v_cvt_f32_i32 v208, v208
  v_cvt_f32_i32 v209, v209
  v_cvt_f32_i32 v210, v210
  v_cvt_f32_i32 v211, v211
  s_waitcnt vmcnt(10)
  v_cvt_f32_i32 v212, v212
  v_cvt_f32_i32 v213, v213
  v_cvt_f32_i32 v214, v214
  v_cvt_f32_i32 v215, v215
  v_cvt_pk_bf16_f32 v98, v208, v212
  v_cvt_pk_bf16_f32 v102, v209, v213
  v_cvt_pk_bf16_f32 v106, v210, v214
  v_cvt_pk_bf16_f32 v110, v211, v215
  s_waitcnt vmcnt(9)
  v_cvt_f32_i32 v216, v216
  v_cvt_f32_i32 v217, v217
  v_cvt_f32_i32 v218, v218
  v_cvt_f32_i32 v219, v219
  s_waitcnt vmcnt(8)
  v_cvt_f32_i32 v220, v220
  v_cvt_f32_i32 v221, v221
  v_cvt_f32_i32 v222, v222
  v_cvt_f32_i32 v223, v223
  v_cvt_pk_bf16_f32 v99, v216, v220
  v_cvt_pk_bf16_f32 v103, v217, v221
  v_cvt_pk_bf16_f32 v107, v218, v222
  v_cvt_pk_bf16_f32 v111, v219, v223
  s_waitcnt vmcnt(7)
  v_cvt_f32_i32 v224, v224
  v_cvt_f32_i32 v225, v225
  v_mfma_f32_16x16x32_bf16 v[32:35], v[76:79], v[96:99], v[32:35]
  v_cvt_f32_i32 v226, v226
  v_mfma_f32_16x16x32_bf16 v[36:39], v[76:79], v[100:103], v[36:39]
  v_cvt_f32_i32 v227, v227
  v_mfma_f32_16x16x32_bf16 v[40:43], v[76:79], v[104:107], v[40:43]
  s_waitcnt vmcnt(6)
  v_cvt_f32_i32 v228, v228
  v_mfma_f32_16x16x32_bf16 v[44:47], v[76:79], v[108:111], v[44:47]
  v_cvt_f32_i32 v229, v229
  v_cvt_f32_i32 v230, v230
  v_cvt_f32_i32 v231, v231
  v_cvt_pk_bf16_f32 v96, v224, v228
  v_cvt_pk_bf16_f32 v100, v225, v229
  v_cvt_pk_bf16_f32 v104, v226, v230
  v_cvt_pk_bf16_f32 v108, v227, v231
  s_waitcnt vmcnt(5)
  v_cvt_f32_i32 v232, v232
  v_cvt_f32_i32 v233, v233
  v_cvt_f32_i32 v234, v234
  v_cvt_f32_i32 v235, v235
  s_waitcnt vmcnt(4)
  v_cvt_f32_i32 v236, v236
  v_cvt_f32_i32 v237, v237
  v_cvt_f32_i32 v238, v238
  v_cvt_f32_i32 v239, v239
  v_cvt_pk_bf16_f32 v97, v232, v236
  v_cvt_pk_bf16_f32 v101, v233, v237
  v_cvt_pk_bf16_f32 v105, v234, v238
  v_cvt_pk_bf16_f32 v109, v235, v239
  v_sub_f32 v128, v32, v64
  v_sub_f32 v129, v36, v64
  v_sub_f32 v130, v40, v64
  v_sub_f32 v131, v44, v64
  ds_write_b128 v115, v[128:131] offset:0
  v_sub_f32 v132, v33, v65
  v_sub_f32 v133, v37, v65
  v_sub_f32 v134, v41, v65
  v_sub_f32 v135, v45, v65
  ds_write_b128 v115, v[132:135] offset:512
  s_waitcnt vmcnt(3)
  v_cvt_f32_i32 v240, v240
  v_cvt_f32_i32 v241, v241
  v_cvt_f32_i32 v242, v242
  v_cvt_f32_i32 v243, v243
  s_waitcnt vmcnt(2)
  v_cvt_f32_i32 v244, v244
  v_cvt_f32_i32 v245, v245
  v_cvt_f32_i32 v246, v246
  v_cvt_f32_i32 v247, v247
  v_cvt_pk_bf16_f32 v98, v240, v244
  v_cvt_pk_bf16_f32 v102, v241, v245
  v_cvt_pk_bf16_f32 v106, v242, v246
  v_cvt_pk_bf16_f32 v110, v243, v247
  v_sub_f32 v136, v34, v66
  v_sub_f32 v137, v38, v66
  v_sub_f32 v138, v42, v66
  v_sub_f32 v139, v46, v66
  ds_write_b128 v115, v[136:139] offset:1024
  v_sub_f32 v140, v35, v67
  v_sub_f32 v141, v39, v67
  v_sub_f32 v142, v43, v67
  v_sub_f32 v143, v47, v67
  ds_write_b128 v115, v[140:143] offset:1536
  s_waitcnt vmcnt(1)
  v_cvt_f32_i32 v248, v248
  v_cvt_f32_i32 v249, v249
  v_cvt_f32_i32 v250, v250
  v_cvt_f32_i32 v251, v251
  s_waitcnt vmcnt(0)
  v_cvt_f32_i32 v252, v252
  v_cvt_f32_i32 v253, v253
  v_cvt_f32_i32 v254, v254
  v_cvt_f32_i32 v255, v255
  v_cvt_pk_bf16_f32 v99, v248, v252
  v_cvt_pk_bf16_f32 v103, v249, v253
  v_cvt_pk_bf16_f32 v107, v250, v254
  v_cvt_pk_bf16_f32 v111, v251, v255
  v_mfma_f32_16x16x32_bf16 v[48:51], v[76:79], v[96:99], v[48:51]
  v_mfma_f32_16x16x32_bf16 v[52:55], v[76:79], v[100:103], v[52:55]
  v_mfma_f32_16x16x32_bf16 v[56:59], v[76:79], v[104:107], v[56:59]
  v_mfma_f32_16x16x32_bf16 v[60:63], v[76:79], v[108:111], v[60:63]
  s_nop 4
  v_sub_f32 v144, v48, v64
  v_sub_f32 v145, v52, v64
  v_sub_f32 v146, v56, v64
  v_sub_f32 v147, v60, v64
  ds_write_b128 v115, v[144:147] offset:256
  v_sub_f32 v148, v49, v65
  v_sub_f32 v149, v53, v65
  v_sub_f32 v150, v57, v65
  v_sub_f32 v151, v61, v65
  ds_write_b128 v115, v[148:151] offset:768
  v_sub_f32 v152, v50, v66
  v_sub_f32 v153, v54, v66
  v_sub_f32 v154, v58, v66
  v_sub_f32 v155, v62, v66
  ds_write_b128 v115, v[152:155] offset:1280
  v_sub_f32 v156, v51, v67
  v_sub_f32 v157, v55, v67
  v_sub_f32 v158, v59, v67
  v_sub_f32 v159, v63, v67
  ds_write_b128 v115, v[156:159] offset:1792
  s_waitcnt lgkmcnt(0)
  s_barrier
L_merge:
  ds_read_b128 v[96:99], v118 offset:16384
  ds_read_b128 v[100:103], v118 offset:16448
  ds_read_b128 v[192:195], v116 offset:0
  ds_read_b128 v[196:199], v116 offset:4096
  ds_read_b128 v[200:203], v116 offset:8192
  ds_read_b128 v[204:207], v116 offset:12288
  s_waitcnt lgkmcnt(4)
  v_max3_f32 v9, v96, v97, v98
  v_max_f32 v9, v9, v99
  v_sub_f32 v96, v96, v9
  v_sub_f32 v97, v97, v9
  v_sub_f32 v98, v98, v9
  v_sub_f32 v99, v99, v9
  v_exp_f32 v96, v96
  v_exp_f32 v97, v97
  v_exp_f32 v98, v98
  v_exp_f32 v99, v99
  s_waitcnt lgkmcnt(0)
  v_mul_f32 v68, v96, v192
  v_mul_f32 v69, v96, v193
  v_mul_f32 v70, v96, v194
  v_mul_f32 v71, v96, v195
  v_mul_f32 v10, v96, v100
  v_fmac_f32 v68, v97, v196
  v_fmac_f32 v69, v97, v197
  v_fmac_f32 v70, v97, v198
  v_fmac_f32 v71, v97, v199
  v_fmac_f32 v10, v97, v101
  v_fmac_f32 v68, v98, v200
  v_fmac_f32 v69, v98, v201
  v_fmac_f32 v70, v98, v202
  v_fmac_f32 v71, v98, v203
  v_fmac_f32 v10, v98, v102
  v_fmac_f32 v68, v99, v204
  v_fmac_f32 v69, v99, v205
  v_fmac_f32 v70, v99, v206
  v_fmac_f32 v71, v99, v207
  v_fmac_f32 v10, v99, v103
  v_mov_b32 v72, v68
  v_mov_b32 v73, v69
  v_mov_b32 v74, v70
  v_mov_b32 v75, v71
  s_nop 0
  v_permlane32_swap_b32 v72, v68
  v_permlane32_swap_b32 v73, v69
  v_permlane32_swap_b32 v74, v70
  v_permlane32_swap_b32 v75, v71
  v_add_f32 v68, v68, v72
  v_add_f32 v69, v69, v73
  v_add_f32 v70, v70, v74
  v_add_f32 v71, v71, v75
  s_mov_b32 exec_lo, 0
  v_mov_b32 v68, v9
  v_mov_b32 v69, v10
  s_mov_b32 exec_lo, -1
  s_mov_b32 exec_hi, 1
  buffer_store_dwordx4 v[68:71], v113, s[40:43], s49 offen sc1
  s_cmp_lg_u32 s24, 0
  s_waitcnt vmcnt(0)
  s_barrier
  s_cbranch_scc1 L_wait0
  s_mov_b64 exec, 1
  global_atomic_add v124, v122, v123, s[20:21] sc0 sc1
  s_mov_b32 exec_lo, -1
  s_mov_b32 exec_hi, 1
  buffer_load_dwordx4 v[192:195], v113, s[40:43], s49 offen sc1
  s_mov_b64 exec, 1
  s_waitcnt vmcnt(1)
  ds_write_b32 v121, v124
  s_waitcnt lgkmcnt(0)
  s_branch L_wait
L_wait0:
  buffer_load_dwordx4 v[192:195], v113, s[40:43], s49 offen sc1
L_wait:
  s_mov_b64 exec, -1
  s_barrier
  ds_read_b32 v124, v121
  s_waitcnt lgkmcnt(0)
  v_readfirstlane_b32 s31, v124
  s_cmp_lg_u32 s31, 31
  s_cbranch_scc1 L_done
L_final:
  buffer_load_dwordx2 v[68:69], v119, s[40:43], s51 offen sc1
  buffer_load_dwordx4 v[128:131], v114, s[40:43], s51 offen sc1
  s_add_u32 s51, s51, 4096
  buffer_load_dwordx4 v[132:135], v114, s[40:43], s51 offen sc1
  s_add_u32 s51, s51, 4096
  buffer_load_dwordx4 v[136:139], v114, s[40:43], s51 offen sc1
  s_add_u32 s51, s51, 4096
  buffer_load_dwordx4 v[140:143], v114, s[40:43], s51 offen sc1
  s_add_u32 s51, s51, 4096
  buffer_load_dwordx4 v[144:147], v114, s[40:43], s51 offen sc1
  s_add_u32 s51, s51, 4096
  buffer_load_dwordx4 v[148:151], v114, s[40:43], s51 offen sc1
  s_add_u32 s51, s51, 4096
  buffer_load_dwordx4 v[152:155], v114, s[40:43], s51 offen sc1
  s_add_u32 s51, s51, 4096
  buffer_load_dwordx4 v[156:159], v114, s[40:43], s51 offen sc1
  s_add_u32 s51, s51, 4096
  v_mov_b32 v76, 0
  v_mov_b32 v77, 0
  v_mov_b32 v78, 0
  v_mov_b32 v79, 0
  s_waitcnt vmcnt(8)
  buffer_load_dwordx4 v[160:163], v114, s[40:43], s51 offen sc1
  s_add_u32 s51, s51, 4096
  buffer_load_dwordx4 v[164:167], v114, s[40:43], s51 offen sc1
  s_add_u32 s51, s51, 4096
  buffer_load_dwordx4 v[168:171], v114, s[40:43], s51 offen sc1
  s_add_u32 s51, s51, 4096
  buffer_load_dwordx4 v[172:175], v114, s[40:43], s51 offen sc1
  s_add_u32 s51, s51, 4096
  buffer_load_dwordx4 v[176:179], v114, s[40:43], s51 offen sc1
  s_add_u32 s51, s51, 4096
  buffer_load_dwordx4 v[180:183], v114, s[40:43], s51 offen sc1
  s_add_u32 s51, s51, 4096
  buffer_load_dwordx4 v[184:187], v114, s[40:43], s51 offen sc1
  s_add_u32 s51, s51, 4096
  buffer_load_dwordx4 v[188:191], v114, s[40:43], s51 offen sc1
  v_max_f32_dpp v9, v68, v68 row_ror:8 row_mask:0xf bank_mask:0xf
  s_nop 1
  v_max_f32_dpp v9, v9, v9 row_ror:4 row_mask:0xf bank_mask:0xf
  s_nop 1
  v_max_f32_dpp v9, v9, v9 row_ror:2 row_mask:0xf bank_mask:0xf
  s_nop 1
  v_max_f32_dpp v9, v9, v9 row_ror:1 row_mask:0xf bank_mask:0xf
  v_mov_b32 v10, v9
  s_nop 1
  v_permlane32_swap_b32 v10, v9
  v_max_f32 v9, v9, v10
  v_sub_f32 v68, v68, v9
  v_exp_f32 v68, v68
  s_nop 0
  v_mul_f32 v9, v68, v69
  s_waitcnt vmcnt(15)
  v_fmac_f32_dpp v76, v68, v128 row_newbcast:0 row_mask:0xf bank_mask:0xf
  v_fmac_f32_dpp v77, v68, v129 row_newbcast:0 row_mask:0xf bank_mask:0xf
  v_fmac_f32_dpp v78, v68, v130 row_newbcast:0 row_mask:0xf bank_mask:0xf
  v_fmac_f32_dpp v79, v68, v131 row_newbcast:0 row_mask:0xf bank_mask:0xf
  v_add_f32_dpp v9, v9, v9 row_ror:8 row_mask:0xf bank_mask:0xf
  s_waitcnt vmcnt(14)
  v_fmac_f32_dpp v76, v68, v132 row_newbcast:1 row_mask:0xf bank_mask:0xf
  v_fmac_f32_dpp v77, v68, v133 row_newbcast:1 row_mask:0xf bank_mask:0xf
  v_fmac_f32_dpp v78, v68, v134 row_newbcast:1 row_mask:0xf bank_mask:0xf
  v_fmac_f32_dpp v79, v68, v135 row_newbcast:1 row_mask:0xf bank_mask:0xf
  v_add_f32_dpp v9, v9, v9 row_ror:4 row_mask:0xf bank_mask:0xf
  s_waitcnt vmcnt(13)
  v_fmac_f32_dpp v76, v68, v136 row_newbcast:2 row_mask:0xf bank_mask:0xf
  v_fmac_f32_dpp v77, v68, v137 row_newbcast:2 row_mask:0xf bank_mask:0xf
  v_fmac_f32_dpp v78, v68, v138 row_newbcast:2 row_mask:0xf bank_mask:0xf
  v_fmac_f32_dpp v79, v68, v139 row_newbcast:2 row_mask:0xf bank_mask:0xf
  v_add_f32_dpp v9, v9, v9 row_ror:2 row_mask:0xf bank_mask:0xf
  s_waitcnt vmcnt(12)
  v_fmac_f32_dpp v76, v68, v140 row_newbcast:3 row_mask:0xf bank_mask:0xf
  v_fmac_f32_dpp v77, v68, v141 row_newbcast:3 row_mask:0xf bank_mask:0xf
  v_fmac_f32_dpp v78, v68, v142 row_newbcast:3 row_mask:0xf bank_mask:0xf
  v_fmac_f32_dpp v79, v68, v143 row_newbcast:3 row_mask:0xf bank_mask:0xf
  v_add_f32_dpp v9, v9, v9 row_ror:1 row_mask:0xf bank_mask:0xf
  s_waitcnt vmcnt(11)
  v_fmac_f32_dpp v76, v68, v144 row_newbcast:4 row_mask:0xf bank_mask:0xf
  v_fmac_f32_dpp v77, v68, v145 row_newbcast:4 row_mask:0xf bank_mask:0xf
  v_fmac_f32_dpp v78, v68, v146 row_newbcast:4 row_mask:0xf bank_mask:0xf
  v_fmac_f32_dpp v79, v68, v147 row_newbcast:4 row_mask:0xf bank_mask:0xf
  v_mov_b32 v10, v9
  s_waitcnt vmcnt(10)
  v_fmac_f32_dpp v76, v68, v148 row_newbcast:5 row_mask:0xf bank_mask:0xf
  v_fmac_f32_dpp v77, v68, v149 row_newbcast:5 row_mask:0xf bank_mask:0xf
  v_fmac_f32_dpp v78, v68, v150 row_newbcast:5 row_mask:0xf bank_mask:0xf
  v_fmac_f32_dpp v79, v68, v151 row_newbcast:5 row_mask:0xf bank_mask:0xf
  v_permlane32_swap_b32 v10, v9
  s_waitcnt vmcnt(9)
  v_fmac_f32_dpp v76, v68, v152 row_newbcast:6 row_mask:0xf bank_mask:0xf
  v_fmac_f32_dpp v77, v68, v153 row_newbcast:6 row_mask:0xf bank_mask:0xf
  v_fmac_f32_dpp v78, v68, v154 row_newbcast:6 row_mask:0xf bank_mask:0xf
  v_fmac_f32_dpp v79, v68, v155 row_newbcast:6 row_mask:0xf bank_mask:0xf
  v_add_f32 v9, v9, v10
  s_waitcnt vmcnt(8)
  v_fmac_f32_dpp v76, v68, v156 row_newbcast:7 row_mask:0xf bank_mask:0xf
  v_fmac_f32_dpp v77, v68, v157 row_newbcast:7 row_mask:0xf bank_mask:0xf
  v_fmac_f32_dpp v78, v68, v158 row_newbcast:7 row_mask:0xf bank_mask:0xf
  v_fmac_f32_dpp v79, v68, v159 row_newbcast:7 row_mask:0xf bank_mask:0xf
  v_rcp_f32 v9, v9
  s_waitcnt vmcnt(7)
  v_fmac_f32_dpp v76, v68, v160 row_newbcast:8 row_mask:0xf bank_mask:0xf
  v_fmac_f32_dpp v77, v68, v161 row_newbcast:8 row_mask:0xf bank_mask:0xf
  v_fmac_f32_dpp v78, v68, v162 row_newbcast:8 row_mask:0xf bank_mask:0xf
  v_fmac_f32_dpp v79, v68, v163 row_newbcast:8 row_mask:0xf bank_mask:0xf
  s_waitcnt vmcnt(6)
  v_fmac_f32_dpp v76, v68, v164 row_newbcast:9 row_mask:0xf bank_mask:0xf
  v_fmac_f32_dpp v77, v68, v165 row_newbcast:9 row_mask:0xf bank_mask:0xf
  v_fmac_f32_dpp v78, v68, v166 row_newbcast:9 row_mask:0xf bank_mask:0xf
  v_fmac_f32_dpp v79, v68, v167 row_newbcast:9 row_mask:0xf bank_mask:0xf
  s_waitcnt vmcnt(5)
  v_fmac_f32_dpp v76, v68, v168 row_newbcast:10 row_mask:0xf bank_mask:0xf
  v_fmac_f32_dpp v77, v68, v169 row_newbcast:10 row_mask:0xf bank_mask:0xf
  v_fmac_f32_dpp v78, v68, v170 row_newbcast:10 row_mask:0xf bank_mask:0xf
  v_fmac_f32_dpp v79, v68, v171 row_newbcast:10 row_mask:0xf bank_mask:0xf
  s_waitcnt vmcnt(4)
  v_fmac_f32_dpp v76, v68, v172 row_newbcast:11 row_mask:0xf bank_mask:0xf
  v_fmac_f32_dpp v77, v68, v173 row_newbcast:11 row_mask:0xf bank_mask:0xf
  v_fmac_f32_dpp v78, v68, v174 row_newbcast:11 row_mask:0xf bank_mask:0xf
  v_fmac_f32_dpp v79, v68, v175 row_newbcast:11 row_mask:0xf bank_mask:0xf
  s_waitcnt vmcnt(3)
  v_fmac_f32_dpp v76, v68, v176 row_newbcast:12 row_mask:0xf bank_mask:0xf
  v_fmac_f32_dpp v77, v68, v177 row_newbcast:12 row_mask:0xf bank_mask:0xf
  v_fmac_f32_dpp v78, v68, v178 row_newbcast:12 row_mask:0xf bank_mask:0xf
  v_fmac_f32_dpp v79, v68, v179 row_newbcast:12 row_mask:0xf bank_mask:0xf
  s_waitcnt vmcnt(2)
  v_fmac_f32_dpp v76, v68, v180 row_newbcast:13 row_mask:0xf bank_mask:0xf
  v_fmac_f32_dpp v77, v68, v181 row_newbcast:13 row_mask:0xf bank_mask:0xf
  v_fmac_f32_dpp v78, v68, v182 row_newbcast:13 row_mask:0xf bank_mask:0xf
  v_fmac_f32_dpp v79, v68, v183 row_newbcast:13 row_mask:0xf bank_mask:0xf
  s_waitcnt vmcnt(1)
  v_fmac_f32_dpp v76, v68, v184 row_newbcast:14 row_mask:0xf bank_mask:0xf
  v_fmac_f32_dpp v77, v68, v185 row_newbcast:14 row_mask:0xf bank_mask:0xf
  v_fmac_f32_dpp v78, v68, v186 row_newbcast:14 row_mask:0xf bank_mask:0xf
  v_fmac_f32_dpp v79, v68, v187 row_newbcast:14 row_mask:0xf bank_mask:0xf
  s_waitcnt vmcnt(0)
  v_fmac_f32_dpp v76, v68, v188 row_newbcast:15 row_mask:0xf bank_mask:0xf
  v_fmac_f32_dpp v77, v68, v189 row_newbcast:15 row_mask:0xf bank_mask:0xf
  v_fmac_f32_dpp v78, v68, v190 row_newbcast:15 row_mask:0xf bank_mask:0xf
  v_fmac_f32_dpp v79, v68, v191 row_newbcast:15 row_mask:0xf bank_mask:0xf
  v_mov_b32 v80, v76
  v_mov_b32 v81, v77
  v_mov_b32 v82, v78
  v_mov_b32 v83, v79
  s_nop 0
  v_permlane32_swap_b32 v80, v76
  v_permlane32_swap_b32 v81, v77
  v_permlane32_swap_b32 v82, v78
  v_permlane32_swap_b32 v83, v79
  v_add_f32 v76, v76, v80
  v_add_f32 v77, v77, v81
  v_add_f32 v78, v78, v82
  v_add_f32 v79, v79, v83
  v_mul_f32 v76, v76, v9
  v_mul_f32 v77, v77, v9
  v_mul_f32 v78, v78, v9
  v_mul_f32 v79, v79, v9
  v_cvt_pk_bf16_f32 v76, v76, v77
  v_cvt_pk_bf16_f32 v77, v78, v79
  s_mov_b32 exec_hi, 0
  global_store_dwordx2 v120, v[76:77], s[18:19]
L_done:
L_end:
  s_endpgm
.section .rodata,"a"
.p2align 6
.amdhsa_kernel standalone__kv_cache_quant_int4_int2_kv_with_per_channel_or_per_token_scales__decode_kernel
  .amdhsa_next_free_vgpr 256
  .amdhsa_next_free_sgpr 56
  .amdhsa_accum_offset 256
  .amdhsa_group_segment_fixed_size 0
  .amdhsa_kernarg_size 80
  .amdhsa_user_sgpr_count 2
  .amdhsa_user_sgpr_kernarg_segment_ptr 1
  .amdhsa_system_sgpr_workgroup_id_x 1
.end_amdhsa_kernel
```
